```python
import torch

def _softmax(x, axis=-1):
    return torch.softmax(x, dim=axis)

def _gelu(x):
    return torch.nn.functional.gelu(x, approximate='tanh')

def _silu(x):
    return torch.nn.functional.silu(x)

def _sigmoid(x):
    return torch.sigmoid(x)

def _layernorm(x, axis=-1, eps=1e-05):
    m = x.mean(dim=axis, keepdim=True)
    v = x.var(dim=axis, keepdim=True, unbiased=False)
    return (x - m) / torch.sqrt(v + eps)

def _scatter_add(tgt, idx, src, axis=0):
    return tgt.clone().index_add_(axis, idx, src)

def _segment_sum(src, seg, n):
    out = torch.zeros((n,) + src.shape[1:], dtype=src.dtype)
    return out.index_add_(0, seg, src)

def _pad(x, pw):
    flat = tuple((v for pair in reversed(pw) for v in pair))
    return torch.nn.functional.pad(x, flat)
kernel_name = 'standalone__tree_speculative_verify_tree_attention_over_candidate_token_tree__decode'

def setup_inputs():

    _w = lambda a: (lambda t: t.to(torch.bfloat16) if t.is_floating_point() else t)(torch.as_tensor(a))
    B, Hq, Hkv, T, C, D = (2, 32, 16, 1, 4096, 128)
    tree_mask = torch.zeros((B, T, T), dtype=float)
    for b in range(B):
        parent = torch.zeros(T, dtype=torch.int64)
        for i in range(1, T):
            parent[i] = int(torch.randint(0, i, (1,)).item())
        for i in range(T):
            j = i
            tree_mask[b, i, j] = 1.0
            while j > 0:
                j = parent[j]
                tree_mask[b, i, j] = 1.0
    return {'q': _w((lambda *s: torch.randn(*s, dtype=torch.bfloat16) * 0.8)(B, Hq, T, D)), 'k_cache': _w((lambda *s: torch.randn(*s, dtype=torch.bfloat16) * 0.8)(B, Hkv, C, D)), 'v_cache': _w((lambda *s: torch.randn(*s, dtype=torch.bfloat16) * 0.05)(B, Hkv, C, D)), 'k_tree': _w((lambda *s: torch.randn(*s, dtype=torch.bfloat16) * 0.8)(B, Hkv, T, D)), 'v_tree': _w((lambda *s: torch.randn(*s, dtype=torch.bfloat16) * 0.05)(B, Hkv, T, D)), 'tree_mask': _w(tree_mask)}

def reference(q, k_cache, v_cache, k_tree, v_tree, tree_mask):
    B, Hq, T, D = q.shape
    Hkv, C = (k_cache.shape[1], k_cache.shape[2])
    rep = Hq // Hkv
    kc = (lambda x, n, axis: torch.repeat_interleave(x, n, dim=axis))(k_cache, rep, axis=1)
    vc = (lambda x, n, axis: torch.repeat_interleave(x, n, dim=axis))(v_cache, rep, axis=1)
    kt = (lambda x, n, axis: torch.repeat_interleave(x, n, dim=axis))(k_tree, rep, axis=1)
    vt = (lambda x, n, axis: torch.repeat_interleave(x, n, dim=axis))(v_tree, rep, axis=1)
    k = torch.concatenate([kc, kt], axis=2)
    v = torch.concatenate([vc, vt], axis=2)
    scale = D ** (-0.5)
    scores = torch.einsum('bhqd,bhkd->bhqk', q, k) * scale
    ctx_mask = torch.ones((B, 1, T, C), dtype=scores.dtype)
    tm = tree_mask[:, None, :, :].clone()
    full_mask = torch.concatenate([ctx_mask, tm], axis=-1)
    scores = scores + (1.0 - full_mask) * -1000000000.0
    p = _softmax(scores, axis=-1)
    return torch.einsum('bhqk,bhkd->bhqd', p, v)
```

```asm
; @launch grid=(256,1,1) block=(320,1,1) lds=4416
.amdgcn_target "amdgcn-amd-amdhsa--gfx950"
.text
.globl standalone__tree_speculative_verify_tree_attention_over_candidate_token_tree__decode_kernel
.p2align 8
.type standalone__tree_speculative_verify_tree_attention_over_candidate_token_tree__decode_kernel,@function
standalone__tree_speculative_verify_tree_attention_over_candidate_token_tree__decode_kernel:
    s_load_dwordx8 s[4:11], s[0:1], 0
    s_cmp_ge_u32 s2, 256
    s_cbranch_scc1 L_end
    v_lshrrev_b32 v2, 6, v0
    v_and_b32 v1, 63, v0
    v_readfirstlane_b32 s24, v2
    s_cmp_eq_u32 s24, 4
    s_cbranch_scc0 L_stream
    s_getpc_b64 s[32:33]
L_pc:
    s_lshr_b32 s3, s2, 3
    s_mulk_i32 s3, 288
    v_lshl_add_u32 v2, v1, 2, s3
    v_min_u32 v2, L_end-L_pc, v2
    v_add_co_u32 v2, vcc, s32, v2
    v_mov_b32 v3, s33
    s_load_dwordx8 s[12:19], s[0:1], 32
    v_addc_co_u32 v3, vcc, 0, v3, vcc
    global_load_dword v160, v[2:3], off
    s_load_dwordx2 s[20:21], s[0:1], 64
    s_barrier
    s_branch L_helper
L_stream:
    s_bitcmp1_b32 s2, 0
    s_cselect_b32 s25, 0x103c900, 0
    s_bitcmp1_b32 s2, 1
    s_cselect_b32 s3, 0x93e900, 0
    s_xor_b32 s25, s25, s3
    s_bitcmp1_b32 s2, 2
    s_cselect_b32 s3, 0x5cc300, 0
    s_xor_b32 s25, s25, s3
    s_bitcmp1_b32 s2, 3
    s_cselect_b32 s3, 0x1b2400, 0
    s_xor_b32 s25, s25, s3
    s_bitcmp1_b32 s2, 4
    s_cselect_b32 s3, 0x2b6300, 0
    s_xor_b32 s25, s25, s3
    s_lshr_b32 s22, s25, 20
    s_bitcmp1_b32 s2, 5
    s_cselect_b32 s3, 0x6e00, 0
    s_xor_b32 s25, s25, s3
    s_bitcmp1_b32 s2, 6
    s_cselect_b32 s3, 0x1b000, 0
    s_xor_b32 s25, s25, s3
    s_bitcmp1_b32 s2, 7
    s_cselect_b32 s3, 0x5de00, 0
    s_xor_b32 s25, s25, s3
    s_bitcmp1_b32 s24, 0
    s_cselect_b32 s3, 0x47000, 0
    s_xor_b32 s25, s25, s3
    s_bitcmp1_b32 s24, 1
    s_cselect_b32 s3, 0x48100, 0
    s_xor_b32 s25, s25, s3
    v_bfe_i32 v2, v0, 2, 1
    v_bfe_i32 v5, v0, 3, 1
    v_bfe_u32 v3, v0, 4, 2
    v_and_b32 v4, 3, v0
    v_and_b32 v2, 0x97b00, v2
    v_and_b32 v8, 0x29600, v5
    v_lshl_add_u32 v3, v3, 2, v4
    v_xor_b32 v8, v8, v2
    v_lshl_add_u32 v8, v3, 4, v8
    v_xor_b32 v8, s25, v8
    s_lshl_b32 s3, s22, 9
    v_and_b32 v5, 1, v5
    v_lshl_add_u32 v3, v3, 4, s3
    v_lshl_add_u32 v3, v5, 8, v3
    s_waitcnt lgkmcnt(0)
    global_load_dwordx4 v[96:99], v8, s[6:7] nt
    global_load_dwordx4 v[20:23], v3, s[4:5]
    v_xor_b32 v8, 0x14400, v8
    global_load_dwordx4 v[100:103], v8, s[6:7] nt
    v_xor_b32 v8, 0x21900, v8
    global_load_dwordx4 v[104:107], v8, s[6:7] nt
    s_barrier
    v_xor_b32 v8, 0x14400, v8
    global_load_dwordx4 v[108:111], v8, s[6:7] nt
    v_xor_b32 v8, 0xe6800, v8
    global_load_dwordx4 v[112:115], v8, s[6:7] nt
    v_xor_b32 v8, 0x14400, v8
    global_load_dwordx4 v[116:119], v8, s[6:7] nt
    v_xor_b32 v8, 0x21900, v8
    global_load_dwordx4 v[120:123], v8, s[6:7] nt
    v_xor_b32 v8, 0x14400, v8
    global_load_dwordx4 v[124:127], v8, s[6:7] nt
    v_xor_b32 v8, 0xdfc00, v8
    global_load_dwordx4 v[128:131], v8, s[6:7] nt
    v_xor_b32 v8, 0x14400, v8
    global_load_dwordx4 v[132:135], v8, s[6:7] nt
    v_xor_b32 v8, 0x21900, v8
    global_load_dwordx4 v[136:139], v8, s[6:7] nt
    v_xor_b32 v8, 0x14400, v8
    global_load_dwordx4 v[140:143], v8, s[6:7] nt
    v_xor_b32 v8, 0xe6800, v8
    global_load_dwordx4 v[144:147], v8, s[6:7] nt
    v_xor_b32 v8, 0x14400, v8
    global_load_dwordx4 v[148:151], v8, s[6:7] nt
    v_xor_b32 v8, 0x21900, v8
    global_load_dwordx4 v[152:155], v8, s[6:7] nt
    v_xor_b32 v8, 0x14400, v8
    global_load_dwordx4 v[156:159], v8, s[6:7] nt
    v_bfe_i32 v2, v0, 4, 1
    v_bfe_i32 v3, v0, 5, 1
    v_and_b32 v4, 15, v0
    v_and_b32 v2, 0x97b00, v2
    v_and_b32 v3, 0x29600, v3
    v_xor_b32 v2, v2, v3
    v_lshl_add_u32 v2, v4, 4, v2
    v_xor_b32 v7, s25, v2
    v_and_b32 v2, 1, v0
    v_lshlrev_b32 v2, 4, v2
    v_mov_b32 v3, 0xffff
    v_lshlrev_b32 v2, v2, v3
    v_bfe_u32 v3, v0, 1, 2
    v_cmp_eq_u32 vcc, 0, v3
    s_nop 1
    v_cndmask_b32 v12, 0, v2, vcc
    v_cmp_eq_u32 vcc, 1, v3
    s_nop 1
    v_cndmask_b32 v13, 0, v2, vcc
    v_cmp_eq_u32 vcc, 2, v3
    s_nop 1
    v_cndmask_b32 v14, 0, v2, vcc
    v_cmp_eq_u32 vcc, 3, v3
    s_nop 1
    v_cndmask_b32 v15, 0, v2, vcc
    v_lshlrev_b32 v4, 5, v5
    s_lshl_b32 s3, s24, 3
    v_add_u32 v4, s3, v4
    v_lshlrev_b32 v5, 4, v0
    s_mov_b32 s26, 0x3fb8aa3b
    s_mov_b32 s27, s26
    s_mov_b32 s28, 0x3db504f3
    s_mov_b32 s29, s28
    s_waitcnt vmcnt(15)
    v_mfma_f32_16x16x32_bf16 v[64:67], v[96:99], v[20:23], 0
    v_xor_b32 v8, 0x4b800, v8
    global_load_dwordx4 v[96:99], v8, s[6:7] nt
    s_waitcnt vmcnt(15)
    v_mfma_f32_16x16x32_bf16 v[68:71], v[100:103], v[20:23], 0
    v_xor_b32 v8, 0x14400, v8
    global_load_dwordx4 v[100:103], v8, s[6:7] nt
    s_waitcnt vmcnt(15)
    v_mfma_f32_16x16x32_bf16 v[72:75], v[104:107], v[20:23], 0
    v_xor_b32 v8, 0x21900, v8
    global_load_dwordx4 v[104:107], v8, s[6:7] nt
    s_waitcnt vmcnt(15)
    v_mfma_f32_16x16x32_bf16 v[76:79], v[108:111], v[20:23], 0
    v_xor_b32 v8, 0x14400, v8
    global_load_dwordx4 v[108:111], v8, s[6:7] nt
    s_nop 3
    s_waitcnt vmcnt(15)
    v_mfma_f32_16x16x32_bf16 v[80:83], v[112:115], v[20:23], 0
    v_xor_b32 v8, 0xe6800, v8
    global_load_dwordx4 v[112:115], v8, s[6:7] nt
    v_mov_b32_dpp v32, v64 quad_perm:[0,0,0,0] row_mask:0xf bank_mask:0xf
    v_mov_b32_dpp v33, v68 quad_perm:[0,0,0,0] row_mask:0xf bank_mask:0xf
    v_mov_b32_dpp v34, v72 quad_perm:[0,0,0,0] row_mask:0xf bank_mask:0xf
    v_mov_b32_dpp v35, v76 quad_perm:[0,0,0,0] row_mask:0xf bank_mask:0xf
    s_waitcnt vmcnt(15)
    v_mfma_f32_16x16x32_bf16 v[84:87], v[116:119], v[20:23], 0
    v_xor_b32 v8, 0x14400, v8
    global_load_dwordx4 v[116:119], v8, s[6:7] nt
    v_add_f32_dpp v32, v65, v32 quad_perm:[1,1,1,1] row_mask:0xf bank_mask:0xf
    v_add_f32_dpp v33, v69, v33 quad_perm:[1,1,1,1] row_mask:0xf bank_mask:0xf
    v_add_f32_dpp v34, v73, v34 quad_perm:[1,1,1,1] row_mask:0xf bank_mask:0xf
    v_add_f32_dpp v35, v77, v35 quad_perm:[1,1,1,1] row_mask:0xf bank_mask:0xf
    s_waitcnt vmcnt(15)
    v_mfma_f32_16x16x32_bf16 v[88:91], v[120:123], v[20:23], 0
    v_xor_b32 v8, 0x21900, v8
    global_load_dwordx4 v[120:123], v8, s[6:7] nt
    v_add_f32_dpp v32, v66, v32 quad_perm:[2,2,2,2] row_mask:0xf bank_mask:0xf
    v_add_f32_dpp v33, v70, v33 quad_perm:[2,2,2,2] row_mask:0xf bank_mask:0xf
    v_add_f32_dpp v34, v74, v34 quad_perm:[2,2,2,2] row_mask:0xf bank_mask:0xf
    v_add_f32_dpp v35, v78, v35 quad_perm:[2,2,2,2] row_mask:0xf bank_mask:0xf
    s_waitcnt vmcnt(15)
    v_mfma_f32_16x16x32_bf16 v[92:95], v[124:127], v[20:23], 0
    v_xor_b32 v8, 0x14400, v8
    global_load_dwordx4 v[124:127], v8, s[6:7] nt
    v_add_f32_dpp v32, v67, v32 quad_perm:[3,3,3,3] row_mask:0xf bank_mask:0xf
    v_add_f32_dpp v33, v71, v33 quad_perm:[3,3,3,3] row_mask:0xf bank_mask:0xf
    v_add_f32_dpp v34, v75, v34 quad_perm:[3,3,3,3] row_mask:0xf bank_mask:0xf
    v_add_f32_dpp v35, v79, v35 quad_perm:[3,3,3,3] row_mask:0xf bank_mask:0xf
    v_cvt_pk_bf16_f32 v32, 0, v32
    v_cvt_pk_bf16_f32 v33, 0, v33
    v_cvt_pk_bf16_f32 v34, 0, v34
    v_cvt_pk_bf16_f32 v35, 0, v35
    v_pk_mul_f32 v[32:33], v[32:33], s[28:29]
    v_pk_mul_f32 v[34:35], v[34:35], s[28:29]
    v_cvt_pk_bf16_f32 v32, 0, v32
    v_cvt_pk_bf16_f32 v33, 0, v33
    v_cvt_pk_bf16_f32 v34, 0, v34
    v_cvt_pk_bf16_f32 v35, 0, v35
    v_pk_mul_f32 v[32:33], v[32:33], s[26:27]
    v_pk_mul_f32 v[34:35], v[34:35], s[26:27]
    v_max3_f32 v10, v32, v33, v34
    v_max_f32 v10, v10, v35
    s_waitcnt vmcnt(15)
    v_mfma_f32_16x16x32_bf16 v[64:67], v[128:131], v[20:23], 0
    v_xor_b32 v8, 0xdfc00, v8
    global_load_dwordx4 v[128:131], v8, s[6:7] nt
    v_mov_b32_dpp v36, v80 quad_perm:[0,0,0,0] row_mask:0xf bank_mask:0xf
    v_mov_b32_dpp v37, v84 quad_perm:[0,0,0,0] row_mask:0xf bank_mask:0xf
    v_mov_b32_dpp v38, v88 quad_perm:[0,0,0,0] row_mask:0xf bank_mask:0xf
    v_mov_b32_dpp v39, v92 quad_perm:[0,0,0,0] row_mask:0xf bank_mask:0xf
    s_waitcnt vmcnt(15)
    v_mfma_f32_16x16x32_bf16 v[68:71], v[132:135], v[20:23], 0
    v_xor_b32 v8, 0x14400, v8
    global_load_dwordx4 v[132:135], v8, s[6:7] nt
    v_add_f32_dpp v36, v81, v36 quad_perm:[1,1,1,1] row_mask:0xf bank_mask:0xf
    v_add_f32_dpp v37, v85, v37 quad_perm:[1,1,1,1] row_mask:0xf bank_mask:0xf
    v_add_f32_dpp v38, v89, v38 quad_perm:[1,1,1,1] row_mask:0xf bank_mask:0xf
    v_add_f32_dpp v39, v93, v39 quad_perm:[1,1,1,1] row_mask:0xf bank_mask:0xf
    s_waitcnt vmcnt(15)
    v_mfma_f32_16x16x32_bf16 v[72:75], v[136:139], v[20:23], 0
    v_xor_b32 v8, 0x21900, v8
    global_load_dwordx4 v[136:139], v8, s[6:7] nt
    v_add_f32_dpp v36, v82, v36 quad_perm:[2,2,2,2] row_mask:0xf bank_mask:0xf
    v_add_f32_dpp v37, v86, v37 quad_perm:[2,2,2,2] row_mask:0xf bank_mask:0xf
    v_add_f32_dpp v38, v90, v38 quad_perm:[2,2,2,2] row_mask:0xf bank_mask:0xf
    v_add_f32_dpp v39, v94, v39 quad_perm:[2,2,2,2] row_mask:0xf bank_mask:0xf
    s_waitcnt vmcnt(15)
    v_mfma_f32_16x16x32_bf16 v[76:79], v[140:143], v[20:23], 0
    v_xor_b32 v8, 0x14400, v8
    global_load_dwordx4 v[140:143], v8, s[6:7] nt
    v_add_f32_dpp v36, v83, v36 quad_perm:[3,3,3,3] row_mask:0xf bank_mask:0xf
    v_add_f32_dpp v37, v87, v37 quad_perm:[3,3,3,3] row_mask:0xf bank_mask:0xf
    v_add_f32_dpp v38, v91, v38 quad_perm:[3,3,3,3] row_mask:0xf bank_mask:0xf
    v_add_f32_dpp v39, v95, v39 quad_perm:[3,3,3,3] row_mask:0xf bank_mask:0xf
    v_cvt_pk_bf16_f32 v36, 0, v36
    v_cvt_pk_bf16_f32 v37, 0, v37
    v_cvt_pk_bf16_f32 v38, 0, v38
    v_cvt_pk_bf16_f32 v39, 0, v39
    v_pk_mul_f32 v[36:37], v[36:37], s[28:29]
    v_pk_mul_f32 v[38:39], v[38:39], s[28:29]
    v_cvt_pk_bf16_f32 v36, 0, v36
    v_cvt_pk_bf16_f32 v37, 0, v37
    v_cvt_pk_bf16_f32 v38, 0, v38
    v_cvt_pk_bf16_f32 v39, 0, v39
    v_pk_mul_f32 v[36:37], v[36:37], s[26:27]
    v_pk_mul_f32 v[38:39], v[38:39], s[26:27]
    v_max3_f32 v10, v10, v36, v37
    v_max3_f32 v10, v10, v38, v39
    s_waitcnt vmcnt(15)
    v_mfma_f32_16x16x32_bf16 v[80:83], v[144:147], v[20:23], 0
    v_xor_b32 v8, 0xe6800, v8
    global_load_dwordx4 v[144:147], v8, s[6:7] nt
    v_mov_b32_dpp v40, v64 quad_perm:[0,0,0,0] row_mask:0xf bank_mask:0xf
    v_mov_b32_dpp v41, v68 quad_perm:[0,0,0,0] row_mask:0xf bank_mask:0xf
    v_mov_b32_dpp v42, v72 quad_perm:[0,0,0,0] row_mask:0xf bank_mask:0xf
    v_mov_b32_dpp v43, v76 quad_perm:[0,0,0,0] row_mask:0xf bank_mask:0xf
    s_waitcnt vmcnt(15)
    v_mfma_f32_16x16x32_bf16 v[84:87], v[148:151], v[20:23], 0
    v_xor_b32 v8, 0x14400, v8
    global_load_dwordx4 v[148:151], v8, s[6:7] nt
    v_add_f32_dpp v40, v65, v40 quad_perm:[1,1,1,1] row_mask:0xf bank_mask:0xf
    v_add_f32_dpp v41, v69, v41 quad_perm:[1,1,1,1] row_mask:0xf bank_mask:0xf
    v_add_f32_dpp v42, v73, v42 quad_perm:[1,1,1,1] row_mask:0xf bank_mask:0xf
    v_add_f32_dpp v43, v77, v43 quad_perm:[1,1,1,1] row_mask:0xf bank_mask:0xf
    s_waitcnt vmcnt(15)
    v_mfma_f32_16x16x32_bf16 v[88:91], v[152:155], v[20:23], 0
    v_xor_b32 v8, 0x21900, v8
    global_load_dwordx4 v[152:155], v8, s[6:7] nt
    v_add_f32_dpp v40, v66, v40 quad_perm:[2,2,2,2] row_mask:0xf bank_mask:0xf
    v_add_f32_dpp v41, v70, v41 quad_perm:[2,2,2,2] row_mask:0xf bank_mask:0xf
    v_add_f32_dpp v42, v74, v42 quad_perm:[2,2,2,2] row_mask:0xf bank_mask:0xf
    v_add_f32_dpp v43, v78, v43 quad_perm:[2,2,2,2] row_mask:0xf bank_mask:0xf
    s_waitcnt vmcnt(15)
    v_mfma_f32_16x16x32_bf16 v[92:95], v[156:159], v[20:23], 0
    v_xor_b32 v8, 0x14400, v8
    global_load_dwordx4 v[156:159], v8, s[6:7] nt
    s_barrier
    v_add_f32_dpp v40, v67, v40 quad_perm:[3,3,3,3] row_mask:0xf bank_mask:0xf
    v_add_f32_dpp v41, v71, v41 quad_perm:[3,3,3,3] row_mask:0xf bank_mask:0xf
    v_add_f32_dpp v42, v75, v42 quad_perm:[3,3,3,3] row_mask:0xf bank_mask:0xf
    v_add_f32_dpp v43, v79, v43 quad_perm:[3,3,3,3] row_mask:0xf bank_mask:0xf
    v_cvt_pk_bf16_f32 v40, 0, v40
    v_cvt_pk_bf16_f32 v41, 0, v41
    v_cvt_pk_bf16_f32 v42, 0, v42
    v_cvt_pk_bf16_f32 v43, 0, v43
    v_pk_mul_f32 v[40:41], v[40:41], s[28:29]
    v_pk_mul_f32 v[42:43], v[42:43], s[28:29]
    v_cvt_pk_bf16_f32 v40, 0, v40
    v_cvt_pk_bf16_f32 v41, 0, v41
    v_cvt_pk_bf16_f32 v42, 0, v42
    v_cvt_pk_bf16_f32 v43, 0, v43
    v_pk_mul_f32 v[40:41], v[40:41], s[26:27]
    v_pk_mul_f32 v[42:43], v[42:43], s[26:27]
    v_max3_f32 v10, v10, v40, v41
    v_max3_f32 v10, v10, v42, v43
    s_waitcnt vmcnt(15)
    v_mfma_f32_16x16x32_bf16 v[64:67], v[96:99], v[20:23], 0
    global_load_dwordx4 v[96:99], v7, s[8:9] nt
    v_mov_b32_dpp v44, v80 quad_perm:[0,0,0,0] row_mask:0xf bank_mask:0xf
    v_mov_b32_dpp v45, v84 quad_perm:[0,0,0,0] row_mask:0xf bank_mask:0xf
    v_mov_b32_dpp v46, v88 quad_perm:[0,0,0,0] row_mask:0xf bank_mask:0xf
    v_mov_b32_dpp v47, v92 quad_perm:[0,0,0,0] row_mask:0xf bank_mask:0xf
    s_waitcnt vmcnt(15)
    v_mfma_f32_16x16x32_bf16 v[68:71], v[100:103], v[20:23], 0
    v_xor_b32 v7, 0x14400, v7
    global_load_dwordx4 v[100:103], v7, s[8:9] nt
    v_add_f32_dpp v44, v81, v44 quad_perm:[1,1,1,1] row_mask:0xf bank_mask:0xf
    v_add_f32_dpp v45, v85, v45 quad_perm:[1,1,1,1] row_mask:0xf bank_mask:0xf
    v_add_f32_dpp v46, v89, v46 quad_perm:[1,1,1,1] row_mask:0xf bank_mask:0xf
    v_add_f32_dpp v47, v93, v47 quad_perm:[1,1,1,1] row_mask:0xf bank_mask:0xf
    s_waitcnt vmcnt(15)
    v_mfma_f32_16x16x32_bf16 v[72:75], v[104:107], v[20:23], 0
    v_xor_b32 v7, 0x21900, v7
    global_load_dwordx4 v[104:107], v7, s[8:9] nt
    v_add_f32_dpp v44, v82, v44 quad_perm:[2,2,2,2] row_mask:0xf bank_mask:0xf
    v_add_f32_dpp v45, v86, v45 quad_perm:[2,2,2,2] row_mask:0xf bank_mask:0xf
    v_add_f32_dpp v46, v90, v46 quad_perm:[2,2,2,2] row_mask:0xf bank_mask:0xf
    v_add_f32_dpp v47, v94, v47 quad_perm:[2,2,2,2] row_mask:0xf bank_mask:0xf
    s_waitcnt vmcnt(15)
    v_mfma_f32_16x16x32_bf16 v[76:79], v[108:111], v[20:23], 0
    v_xor_b32 v7, 0x14400, v7
    global_load_dwordx4 v[108:111], v7, s[8:9] nt
    v_add_f32_dpp v44, v83, v44 quad_perm:[3,3,3,3] row_mask:0xf bank_mask:0xf
    v_add_f32_dpp v45, v87, v45 quad_perm:[3,3,3,3] row_mask:0xf bank_mask:0xf
    v_add_f32_dpp v46, v91, v46 quad_perm:[3,3,3,3] row_mask:0xf bank_mask:0xf
    v_add_f32_dpp v47, v95, v47 quad_perm:[3,3,3,3] row_mask:0xf bank_mask:0xf
    v_cvt_pk_bf16_f32 v44, 0, v44
    v_cvt_pk_bf16_f32 v45, 0, v45
    v_cvt_pk_bf16_f32 v46, 0, v46
    v_cvt_pk_bf16_f32 v47, 0, v47
    v_pk_mul_f32 v[44:45], v[44:45], s[28:29]
    v_pk_mul_f32 v[46:47], v[46:47], s[28:29]
    v_cvt_pk_bf16_f32 v44, 0, v44
    v_cvt_pk_bf16_f32 v45, 0, v45
    v_cvt_pk_bf16_f32 v46, 0, v46
    v_cvt_pk_bf16_f32 v47, 0, v47
    v_pk_mul_f32 v[44:45], v[44:45], s[26:27]
    v_pk_mul_f32 v[46:47], v[46:47], s[26:27]
    v_max3_f32 v10, v10, v44, v45
    v_max3_f32 v10, v10, v46, v47
    s_waitcnt vmcnt(15)
    v_mfma_f32_16x16x32_bf16 v[80:83], v[112:115], v[20:23], 0
    v_xor_b32 v7, 0xe6800, v7
    global_load_dwordx4 v[112:115], v7, s[8:9] nt
    v_mov_b32_dpp v48, v64 quad_perm:[0,0,0,0] row_mask:0xf bank_mask:0xf
    v_mov_b32_dpp v49, v68 quad_perm:[0,0,0,0] row_mask:0xf bank_mask:0xf
    v_mov_b32_dpp v50, v72 quad_perm:[0,0,0,0] row_mask:0xf bank_mask:0xf
    v_mov_b32_dpp v51, v76 quad_perm:[0,0,0,0] row_mask:0xf bank_mask:0xf
    s_waitcnt vmcnt(15)
    v_mfma_f32_16x16x32_bf16 v[84:87], v[116:119], v[20:23], 0
    v_xor_b32 v7, 0x14400, v7
    global_load_dwordx4 v[116:119], v7, s[8:9] nt
    v_add_f32_dpp v48, v65, v48 quad_perm:[1,1,1,1] row_mask:0xf bank_mask:0xf
    v_add_f32_dpp v49, v69, v49 quad_perm:[1,1,1,1] row_mask:0xf bank_mask:0xf
    v_add_f32_dpp v50, v73, v50 quad_perm:[1,1,1,1] row_mask:0xf bank_mask:0xf
    v_add_f32_dpp v51, v77, v51 quad_perm:[1,1,1,1] row_mask:0xf bank_mask:0xf
    s_waitcnt vmcnt(15)
    v_mfma_f32_16x16x32_bf16 v[88:91], v[120:123], v[20:23], 0
    v_xor_b32 v7, 0x21900, v7
    global_load_dwordx4 v[120:123], v7, s[8:9] nt
    v_add_f32_dpp v48, v66, v48 quad_perm:[2,2,2,2] row_mask:0xf bank_mask:0xf
    v_add_f32_dpp v49, v70, v49 quad_perm:[2,2,2,2] row_mask:0xf bank_mask:0xf
    v_add_f32_dpp v50, v74, v50 quad_perm:[2,2,2,2] row_mask:0xf bank_mask:0xf
    v_add_f32_dpp v51, v78, v51 quad_perm:[2,2,2,2] row_mask:0xf bank_mask:0xf
    s_waitcnt vmcnt(15)
    v_mfma_f32_16x16x32_bf16 v[92:95], v[124:127], v[20:23], 0
    v_xor_b32 v7, 0x14400, v7
    global_load_dwordx4 v[124:127], v7, s[8:9] nt
    v_add_f32_dpp v48, v67, v48 quad_perm:[3,3,3,3] row_mask:0xf bank_mask:0xf
    v_add_f32_dpp v49, v71, v49 quad_perm:[3,3,3,3] row_mask:0xf bank_mask:0xf
    v_add_f32_dpp v50, v75, v50 quad_perm:[3,3,3,3] row_mask:0xf bank_mask:0xf
    v_add_f32_dpp v51, v79, v51 quad_perm:[3,3,3,3] row_mask:0xf bank_mask:0xf
    v_cvt_pk_bf16_f32 v48, 0, v48
    v_cvt_pk_bf16_f32 v49, 0, v49
    v_cvt_pk_bf16_f32 v50, 0, v50
    v_cvt_pk_bf16_f32 v51, 0, v51
    v_pk_mul_f32 v[48:49], v[48:49], s[28:29]
    v_pk_mul_f32 v[50:51], v[50:51], s[28:29]
    v_cvt_pk_bf16_f32 v48, 0, v48
    v_cvt_pk_bf16_f32 v49, 0, v49
    v_cvt_pk_bf16_f32 v50, 0, v50
    v_cvt_pk_bf16_f32 v51, 0, v51
    v_pk_mul_f32 v[48:49], v[48:49], s[26:27]
    v_pk_mul_f32 v[50:51], v[50:51], s[26:27]
    v_max3_f32 v10, v10, v48, v49
    v_max3_f32 v10, v10, v50, v51
    s_waitcnt vmcnt(15)
    v_mfma_f32_16x16x32_bf16 v[64:67], v[128:131], v[20:23], 0
    v_xor_b32 v7, 0xdfc00, v7
    global_load_dwordx4 v[128:131], v7, s[8:9] nt
    s_barrier
    v_mov_b32_dpp v52, v80 quad_perm:[0,0,0,0] row_mask:0xf bank_mask:0xf
    v_mov_b32_dpp v53, v84 quad_perm:[0,0,0,0] row_mask:0xf bank_mask:0xf
    v_mov_b32_dpp v54, v88 quad_perm:[0,0,0,0] row_mask:0xf bank_mask:0xf
    v_mov_b32_dpp v55, v92 quad_perm:[0,0,0,0] row_mask:0xf bank_mask:0xf
    s_waitcnt vmcnt(15)
    v_mfma_f32_16x16x32_bf16 v[68:71], v[132:135], v[20:23], 0
    v_xor_b32 v7, 0x14400, v7
    global_load_dwordx4 v[132:135], v7, s[8:9] nt
    v_add_f32_dpp v52, v81, v52 quad_perm:[1,1,1,1] row_mask:0xf bank_mask:0xf
    v_add_f32_dpp v53, v85, v53 quad_perm:[1,1,1,1] row_mask:0xf bank_mask:0xf
    v_add_f32_dpp v54, v89, v54 quad_perm:[1,1,1,1] row_mask:0xf bank_mask:0xf
    v_add_f32_dpp v55, v93, v55 quad_perm:[1,1,1,1] row_mask:0xf bank_mask:0xf
    s_waitcnt vmcnt(15)
    v_mfma_f32_16x16x32_bf16 v[72:75], v[136:139], v[20:23], 0
    v_xor_b32 v7, 0x21900, v7
    global_load_dwordx4 v[136:139], v7, s[8:9] nt
    v_add_f32_dpp v52, v82, v52 quad_perm:[2,2,2,2] row_mask:0xf bank_mask:0xf
    v_add_f32_dpp v53, v86, v53 quad_perm:[2,2,2,2] row_mask:0xf bank_mask:0xf
    v_add_f32_dpp v54, v90, v54 quad_perm:[2,2,2,2] row_mask:0xf bank_mask:0xf
    v_add_f32_dpp v55, v94, v55 quad_perm:[2,2,2,2] row_mask:0xf bank_mask:0xf
    s_waitcnt vmcnt(15)
    v_mfma_f32_16x16x32_bf16 v[76:79], v[140:143], v[20:23], 0
    v_xor_b32 v7, 0x14400, v7
    global_load_dwordx4 v[140:143], v7, s[8:9] nt
    v_add_f32_dpp v52, v83, v52 quad_perm:[3,3,3,3] row_mask:0xf bank_mask:0xf
    v_add_f32_dpp v53, v87, v53 quad_perm:[3,3,3,3] row_mask:0xf bank_mask:0xf
    v_add_f32_dpp v54, v91, v54 quad_perm:[3,3,3,3] row_mask:0xf bank_mask:0xf
    v_add_f32_dpp v55, v95, v55 quad_perm:[3,3,3,3] row_mask:0xf bank_mask:0xf
    v_cvt_pk_bf16_f32 v52, 0, v52
    v_cvt_pk_bf16_f32 v53, 0, v53
    v_cvt_pk_bf16_f32 v54, 0, v54
    v_cvt_pk_bf16_f32 v55, 0, v55
    v_pk_mul_f32 v[52:53], v[52:53], s[28:29]
    v_pk_mul_f32 v[54:55], v[54:55], s[28:29]
    v_cvt_pk_bf16_f32 v52, 0, v52
    v_cvt_pk_bf16_f32 v53, 0, v53
    v_cvt_pk_bf16_f32 v54, 0, v54
    v_cvt_pk_bf16_f32 v55, 0, v55
    v_pk_mul_f32 v[52:53], v[52:53], s[26:27]
    v_pk_mul_f32 v[54:55], v[54:55], s[26:27]
    v_max3_f32 v10, v10, v52, v53
    v_max3_f32 v10, v10, v54, v55
    s_waitcnt vmcnt(15)
    v_mfma_f32_16x16x32_bf16 v[80:83], v[144:147], v[20:23], 0
    v_xor_b32 v7, 0xe6800, v7
    global_load_dwordx4 v[144:147], v7, s[8:9] nt
    v_mov_b32_dpp v56, v64 quad_perm:[0,0,0,0] row_mask:0xf bank_mask:0xf
    v_mov_b32_dpp v57, v68 quad_perm:[0,0,0,0] row_mask:0xf bank_mask:0xf
    v_mov_b32_dpp v58, v72 quad_perm:[0,0,0,0] row_mask:0xf bank_mask:0xf
    v_mov_b32_dpp v59, v76 quad_perm:[0,0,0,0] row_mask:0xf bank_mask:0xf
    s_waitcnt vmcnt(15)
    v_mfma_f32_16x16x32_bf16 v[84:87], v[148:151], v[20:23], 0
    v_xor_b32 v7, 0x14400, v7
    global_load_dwordx4 v[148:151], v7, s[8:9] nt
    v_add_f32_dpp v56, v65, v56 quad_perm:[1,1,1,1] row_mask:0xf bank_mask:0xf
    v_add_f32_dpp v57, v69, v57 quad_perm:[1,1,1,1] row_mask:0xf bank_mask:0xf
    v_add_f32_dpp v58, v73, v58 quad_perm:[1,1,1,1] row_mask:0xf bank_mask:0xf
    v_add_f32_dpp v59, v77, v59 quad_perm:[1,1,1,1] row_mask:0xf bank_mask:0xf
    s_waitcnt vmcnt(15)
    v_mfma_f32_16x16x32_bf16 v[88:91], v[152:155], v[20:23], 0
    v_xor_b32 v7, 0x21900, v7
    global_load_dwordx4 v[152:155], v7, s[8:9] nt
    v_add_f32_dpp v56, v66, v56 quad_perm:[2,2,2,2] row_mask:0xf bank_mask:0xf
    v_add_f32_dpp v57, v70, v57 quad_perm:[2,2,2,2] row_mask:0xf bank_mask:0xf
    v_add_f32_dpp v58, v74, v58 quad_perm:[2,2,2,2] row_mask:0xf bank_mask:0xf
    v_add_f32_dpp v59, v78, v59 quad_perm:[2,2,2,2] row_mask:0xf bank_mask:0xf
    s_waitcnt vmcnt(15)
    v_mfma_f32_16x16x32_bf16 v[92:95], v[156:159], v[20:23], 0
    v_xor_b32 v7, 0x14400, v7
    global_load_dwordx4 v[156:159], v7, s[8:9] nt
    s_barrier
    v_add_f32_dpp v56, v67, v56 quad_perm:[3,3,3,3] row_mask:0xf bank_mask:0xf
    v_add_f32_dpp v57, v71, v57 quad_perm:[3,3,3,3] row_mask:0xf bank_mask:0xf
    v_add_f32_dpp v58, v75, v58 quad_perm:[3,3,3,3] row_mask:0xf bank_mask:0xf
    v_add_f32_dpp v59, v79, v59 quad_perm:[3,3,3,3] row_mask:0xf bank_mask:0xf
    v_cvt_pk_bf16_f32 v56, 0, v56
    v_cvt_pk_bf16_f32 v57, 0, v57
    v_cvt_pk_bf16_f32 v58, 0, v58
    v_cvt_pk_bf16_f32 v59, 0, v59
    v_pk_mul_f32 v[56:57], v[56:57], s[28:29]
    v_pk_mul_f32 v[58:59], v[58:59], s[28:29]
    v_cvt_pk_bf16_f32 v56, 0, v56
    v_cvt_pk_bf16_f32 v57, 0, v57
    v_cvt_pk_bf16_f32 v58, 0, v58
    v_cvt_pk_bf16_f32 v59, 0, v59
    v_pk_mul_f32 v[56:57], v[56:57], s[26:27]
    v_pk_mul_f32 v[58:59], v[58:59], s[26:27]
    v_max3_f32 v10, v10, v56, v57
    v_max3_f32 v10, v10, v58, v59
    v_mov_b32_dpp v60, v80 quad_perm:[0,0,0,0] row_mask:0xf bank_mask:0xf
    v_mov_b32_dpp v61, v84 quad_perm:[0,0,0,0] row_mask:0xf bank_mask:0xf
    v_mov_b32_dpp v62, v88 quad_perm:[0,0,0,0] row_mask:0xf bank_mask:0xf
    v_mov_b32_dpp v63, v92 quad_perm:[0,0,0,0] row_mask:0xf bank_mask:0xf
    v_add_f32_dpp v60, v81, v60 quad_perm:[1,1,1,1] row_mask:0xf bank_mask:0xf
    v_add_f32_dpp v61, v85, v61 quad_perm:[1,1,1,1] row_mask:0xf bank_mask:0xf
    v_add_f32_dpp v62, v89, v62 quad_perm:[1,1,1,1] row_mask:0xf bank_mask:0xf
    v_add_f32_dpp v63, v93, v63 quad_perm:[1,1,1,1] row_mask:0xf bank_mask:0xf
    v_add_f32_dpp v60, v82, v60 quad_perm:[2,2,2,2] row_mask:0xf bank_mask:0xf
    v_add_f32_dpp v61, v86, v61 quad_perm:[2,2,2,2] row_mask:0xf bank_mask:0xf
    v_add_f32_dpp v62, v90, v62 quad_perm:[2,2,2,2] row_mask:0xf bank_mask:0xf
    v_add_f32_dpp v63, v94, v63 quad_perm:[2,2,2,2] row_mask:0xf bank_mask:0xf
    v_add_f32_dpp v60, v83, v60 quad_perm:[3,3,3,3] row_mask:0xf bank_mask:0xf
    v_add_f32_dpp v61, v87, v61 quad_perm:[3,3,3,3] row_mask:0xf bank_mask:0xf
    v_add_f32_dpp v62, v91, v62 quad_perm:[3,3,3,3] row_mask:0xf bank_mask:0xf
    v_add_f32_dpp v63, v95, v63 quad_perm:[3,3,3,3] row_mask:0xf bank_mask:0xf
    v_cvt_pk_bf16_f32 v60, 0, v60
    v_cvt_pk_bf16_f32 v61, 0, v61
    v_cvt_pk_bf16_f32 v62, 0, v62
    v_cvt_pk_bf16_f32 v63, 0, v63
    v_pk_mul_f32 v[60:61], v[60:61], s[28:29]
    v_pk_mul_f32 v[62:63], v[62:63], s[28:29]
    v_cvt_pk_bf16_f32 v60, 0, v60
    v_cvt_pk_bf16_f32 v61, 0, v61
    v_cvt_pk_bf16_f32 v62, 0, v62
    v_cvt_pk_bf16_f32 v63, 0, v63
    v_pk_mul_f32 v[60:61], v[60:61], s[26:27]
    v_pk_mul_f32 v[62:63], v[62:63], s[26:27]
    v_max3_f32 v10, v10, v60, v61
    v_max3_f32 v10, v10, v62, v63
    v_mov_b32 v2, v10
    s_nop 1
    v_permlane32_swap_b32 v10, v2
    s_nop 0
    v_max_f32 v10, v10, v2
    v_mov_b32 v2, v10
    s_nop 1
    v_permlane16_swap_b32 v10, v2
    s_nop 0
    v_max_f32 v10, v10, v2
    v_pk_add_f32 v[32:33], v[32:33], v[10:11] op_sel_hi:[1,0] neg_lo:[0,1] neg_hi:[0,1]
    v_pk_add_f32 v[34:35], v[34:35], v[10:11] op_sel_hi:[1,0] neg_lo:[0,1] neg_hi:[0,1]
    v_exp_f32 v32, v32
    v_exp_f32 v33, v33
    v_exp_f32 v34, v34
    v_exp_f32 v35, v35
    v_add_f32 v11, v32, v33
    v_add_f32 v11, v11, v34
    v_add_f32 v11, v11, v35
    v_cvt_pk_bf16_f32 v32, v32, v32
    v_cvt_pk_bf16_f32 v33, v33, v33
    v_cvt_pk_bf16_f32 v34, v34, v34
    v_cvt_pk_bf16_f32 v35, v35, v35
    v_and_b32 v24, v12, v32
    v_and_b32 v25, v13, v32
    v_and_b32 v26, v14, v32
    v_and_b32 v27, v15, v32
    v_pk_add_f32 v[36:37], v[36:37], v[10:11] op_sel_hi:[1,0] neg_lo:[0,1] neg_hi:[0,1]
    v_pk_add_f32 v[38:39], v[38:39], v[10:11] op_sel_hi:[1,0] neg_lo:[0,1] neg_hi:[0,1]
    v_exp_f32 v36, v36
    v_exp_f32 v37, v37
    v_exp_f32 v38, v38
    v_exp_f32 v39, v39
    v_add_f32 v11, v11, v36
    v_add_f32 v11, v11, v37
    v_add_f32 v11, v11, v38
    v_add_f32 v11, v11, v39
    v_cvt_pk_bf16_f32 v36, v36, v36
    v_cvt_pk_bf16_f32 v37, v37, v37
    v_cvt_pk_bf16_f32 v38, v38, v38
    v_cvt_pk_bf16_f32 v39, v39, v39
    v_and_b32 v28, v12, v33
    v_and_b32 v29, v13, v33
    v_and_b32 v30, v14, v33
    v_and_b32 v31, v15, v33
    s_waitcnt vmcnt(15)
    v_mfma_f32_16x16x32_bf16 v[16:19], v[24:27], v[96:99], 0
    v_xor_b32 v7, 0x4b800, v7
    global_load_dwordx4 v[96:99], v7, s[8:9] nt
    v_pk_add_f32 v[40:41], v[40:41], v[10:11] op_sel_hi:[1,0] neg_lo:[0,1] neg_hi:[0,1]
    v_pk_add_f32 v[42:43], v[42:43], v[10:11] op_sel_hi:[1,0] neg_lo:[0,1] neg_hi:[0,1]
    v_exp_f32 v40, v40
    v_exp_f32 v41, v41
    v_exp_f32 v42, v42
    v_exp_f32 v43, v43
    v_add_f32 v11, v11, v40
    v_add_f32 v11, v11, v41
    v_add_f32 v11, v11, v42
    v_add_f32 v11, v11, v43
    v_cvt_pk_bf16_f32 v40, v40, v40
    v_cvt_pk_bf16_f32 v41, v41, v41
    v_cvt_pk_bf16_f32 v42, v42, v42
    v_cvt_pk_bf16_f32 v43, v43, v43
    v_and_b32 v24, v12, v34
    v_and_b32 v25, v13, v34
    v_and_b32 v26, v14, v34
    v_and_b32 v27, v15, v34
    s_waitcnt vmcnt(15)
    v_mfma_f32_16x16x32_bf16 v[16:19], v[28:31], v[100:103], v[16:19]
    v_xor_b32 v7, 0x14400, v7
    global_load_dwordx4 v[100:103], v7, s[8:9] nt
    v_pk_add_f32 v[44:45], v[44:45], v[10:11] op_sel_hi:[1,0] neg_lo:[0,1] neg_hi:[0,1]
    v_pk_add_f32 v[46:47], v[46:47], v[10:11] op_sel_hi:[1,0] neg_lo:[0,1] neg_hi:[0,1]
    v_exp_f32 v44, v44
    v_exp_f32 v45, v45
    v_exp_f32 v46, v46
    v_exp_f32 v47, v47
    v_add_f32 v11, v11, v44
    v_add_f32 v11, v11, v45
    v_add_f32 v11, v11, v46
    v_add_f32 v11, v11, v47
    v_cvt_pk_bf16_f32 v44, v44, v44
    v_cvt_pk_bf16_f32 v45, v45, v45
    v_cvt_pk_bf16_f32 v46, v46, v46
    v_cvt_pk_bf16_f32 v47, v47, v47
    v_and_b32 v28, v12, v35
    v_and_b32 v29, v13, v35
    v_and_b32 v30, v14, v35
    v_and_b32 v31, v15, v35
    s_waitcnt vmcnt(15)
    v_mfma_f32_16x16x32_bf16 v[16:19], v[24:27], v[104:107], v[16:19]
    v_xor_b32 v7, 0x21900, v7
    global_load_dwordx4 v[104:107], v7, s[8:9] nt
    v_pk_add_f32 v[48:49], v[48:49], v[10:11] op_sel_hi:[1,0] neg_lo:[0,1] neg_hi:[0,1]
    v_pk_add_f32 v[50:51], v[50:51], v[10:11] op_sel_hi:[1,0] neg_lo:[0,1] neg_hi:[0,1]
    v_exp_f32 v48, v48
    v_exp_f32 v49, v49
    v_exp_f32 v50, v50
    v_exp_f32 v51, v51
    v_add_f32 v11, v11, v48
    v_add_f32 v11, v11, v49
    v_add_f32 v11, v11, v50
    v_add_f32 v11, v11, v51
    v_cvt_pk_bf16_f32 v48, v48, v48
    v_cvt_pk_bf16_f32 v49, v49, v49
    v_cvt_pk_bf16_f32 v50, v50, v50
    v_cvt_pk_bf16_f32 v51, v51, v51
    v_and_b32 v24, v12, v36
    v_and_b32 v25, v13, v36
    v_and_b32 v26, v14, v36
    v_and_b32 v27, v15, v36
    s_waitcnt vmcnt(15)
    v_mfma_f32_16x16x32_bf16 v[16:19], v[28:31], v[108:111], v[16:19]
    v_xor_b32 v7, 0x14400, v7
    global_load_dwordx4 v[108:111], v7, s[8:9] nt
    v_pk_add_f32 v[52:53], v[52:53], v[10:11] op_sel_hi:[1,0] neg_lo:[0,1] neg_hi:[0,1]
    v_pk_add_f32 v[54:55], v[54:55], v[10:11] op_sel_hi:[1,0] neg_lo:[0,1] neg_hi:[0,1]
    v_exp_f32 v52, v52
    v_exp_f32 v53, v53
    v_exp_f32 v54, v54
    v_exp_f32 v55, v55
    v_add_f32 v11, v11, v52
    v_add_f32 v11, v11, v53
    v_add_f32 v11, v11, v54
    v_add_f32 v11, v11, v55
    v_cvt_pk_bf16_f32 v52, v52, v52
    v_cvt_pk_bf16_f32 v53, v53, v53
    v_cvt_pk_bf16_f32 v54, v54, v54
    v_cvt_pk_bf16_f32 v55, v55, v55
    v_and_b32 v28, v12, v37
    v_and_b32 v29, v13, v37
    v_and_b32 v30, v14, v37
    v_and_b32 v31, v15, v37
    s_waitcnt vmcnt(15)
    v_mfma_f32_16x16x32_bf16 v[16:19], v[24:27], v[112:115], v[16:19]
    v_xor_b32 v7, 0xe6800, v7
    global_load_dwordx4 v[112:115], v7, s[8:9] nt
    v_pk_add_f32 v[56:57], v[56:57], v[10:11] op_sel_hi:[1,0] neg_lo:[0,1] neg_hi:[0,1]
    v_pk_add_f32 v[58:59], v[58:59], v[10:11] op_sel_hi:[1,0] neg_lo:[0,1] neg_hi:[0,1]
    v_exp_f32 v56, v56
    v_exp_f32 v57, v57
    v_exp_f32 v58, v58
    v_exp_f32 v59, v59
    v_add_f32 v11, v11, v56
    v_add_f32 v11, v11, v57
    v_add_f32 v11, v11, v58
    v_add_f32 v11, v11, v59
    v_cvt_pk_bf16_f32 v56, v56, v56
    v_cvt_pk_bf16_f32 v57, v57, v57
    v_cvt_pk_bf16_f32 v58, v58, v58
    v_cvt_pk_bf16_f32 v59, v59, v59
    v_and_b32 v24, v12, v38
    v_and_b32 v25, v13, v38
    v_and_b32 v26, v14, v38
    v_and_b32 v27, v15, v38
    s_waitcnt vmcnt(15)
    v_mfma_f32_16x16x32_bf16 v[16:19], v[28:31], v[116:119], v[16:19]
    v_xor_b32 v7, 0x14400, v7
    global_load_dwordx4 v[116:119], v7, s[8:9] nt
    v_pk_add_f32 v[60:61], v[60:61], v[10:11] op_sel_hi:[1,0] neg_lo:[0,1] neg_hi:[0,1]
    v_pk_add_f32 v[62:63], v[62:63], v[10:11] op_sel_hi:[1,0] neg_lo:[0,1] neg_hi:[0,1]
    v_exp_f32 v60, v60
    v_exp_f32 v61, v61
    v_exp_f32 v62, v62
    v_exp_f32 v63, v63
    v_add_f32 v11, v11, v60
    v_add_f32 v11, v11, v61
    v_add_f32 v11, v11, v62
    v_add_f32 v11, v11, v63
    v_cvt_pk_bf16_f32 v60, v60, v60
    v_cvt_pk_bf16_f32 v61, v61, v61
    v_cvt_pk_bf16_f32 v62, v62, v62
    v_cvt_pk_bf16_f32 v63, v63, v63
    v_and_b32 v28, v12, v39
    v_and_b32 v29, v13, v39
    v_and_b32 v30, v14, v39
    v_and_b32 v31, v15, v39
    s_waitcnt vmcnt(15)
    v_mfma_f32_16x16x32_bf16 v[16:19], v[24:27], v[120:123], v[16:19]
    v_xor_b32 v7, 0x21900, v7
    global_load_dwordx4 v[120:123], v7, s[8:9] nt
    v_and_b32 v24, v12, v40
    v_and_b32 v25, v13, v40
    v_and_b32 v26, v14, v40
    v_and_b32 v27, v15, v40
    v_mov_b32 v2, v11
    s_nop 1
    v_permlane32_swap_b32 v11, v2
    s_nop 0
    v_add_f32 v11, v11, v2
    v_mov_b32 v2, v11
    s_nop 1
    v_permlane16_swap_b32 v11, v2
    s_nop 0
    v_add_f32 v11, v11, v2
    s_mov_b64 exec, 0x101
    ds_write_b64 v4, v[10:11] offset:4096
    s_mov_b64 exec, -1
    s_waitcnt vmcnt(15)
    v_mfma_f32_16x16x32_bf16 v[16:19], v[28:31], v[124:127], v[16:19]
    v_xor_b32 v7, 0x14400, v7
    global_load_dwordx4 v[124:127], v7, s[8:9] nt
    v_and_b32 v28, v12, v41
    v_and_b32 v29, v13, v41
    v_and_b32 v30, v14, v41
    v_and_b32 v31, v15, v41
    v_and_b32 v64, v12, v56
    v_and_b32 v65, v13, v56
    v_and_b32 v66, v14, v56
    v_and_b32 v67, v15, v56
    s_waitcnt vmcnt(15)
    v_mfma_f32_16x16x32_bf16 v[16:19], v[24:27], v[128:131], v[16:19]
    v_xor_b32 v7, 0xdfc00, v7
    global_load_dwordx4 v[128:131], v7, s[8:9] nt
    v_and_b32 v24, v12, v42
    v_and_b32 v25, v13, v42
    v_and_b32 v26, v14, v42
    v_and_b32 v27, v15, v42
    v_and_b32 v68, v12, v57
    v_and_b32 v69, v13, v57
    v_and_b32 v70, v14, v57
    v_and_b32 v71, v15, v57
    s_waitcnt vmcnt(15)
    v_mfma_f32_16x16x32_bf16 v[16:19], v[28:31], v[132:135], v[16:19]
    v_xor_b32 v7, 0x14400, v7
    global_load_dwordx4 v[132:135], v7, s[8:9] nt
    s_lshr_b32 s23, s2, 5
    s_cmp_eq_u32 s24, 3
    s_cselect_b32 s3, s23, 0
    s_cmp_lg_u32 s3, 0
    s_cbranch_scc1 L_last
    v_and_b32 v28, v12, v43
    v_and_b32 v29, v13, v43
    v_and_b32 v30, v14, v43
    v_and_b32 v31, v15, v43
    v_and_b32 v72, v12, v58
    v_and_b32 v73, v13, v58
    v_and_b32 v74, v14, v58
    v_and_b32 v75, v15, v58
    s_waitcnt vmcnt(15)
    v_mfma_f32_16x16x32_bf16 v[16:19], v[24:27], v[136:139], v[16:19]
    v_xor_b32 v7, 0x21900, v7
    global_load_dwordx4 v[136:139], v7, s[8:9] nt
    v_and_b32 v24, v12, v44
    v_and_b32 v25, v13, v44
    v_and_b32 v26, v14, v44
    v_and_b32 v27, v15, v44
    v_and_b32 v76, v12, v59
    v_and_b32 v77, v13, v59
    v_and_b32 v78, v14, v59
    v_and_b32 v79, v15, v59
    s_waitcnt vmcnt(15)
    v_mfma_f32_16x16x32_bf16 v[16:19], v[28:31], v[140:143], v[16:19]
    v_xor_b32 v7, 0x14400, v7
    global_load_dwordx4 v[140:143], v7, s[8:9] nt
    v_and_b32 v28, v12, v45
    v_and_b32 v29, v13, v45
    v_and_b32 v30, v14, v45
    v_and_b32 v31, v15, v45
    v_and_b32 v80, v12, v60
    v_and_b32 v81, v13, v60
    v_and_b32 v82, v14, v60
    v_and_b32 v83, v15, v60
    s_waitcnt vmcnt(15)
    v_mfma_f32_16x16x32_bf16 v[16:19], v[24:27], v[144:147], v[16:19]
    v_xor_b32 v7, 0xe6800, v7
    global_load_dwordx4 v[144:147], v7, s[8:9] nt
    v_and_b32 v24, v12, v46
    v_and_b32 v25, v13, v46
    v_and_b32 v26, v14, v46
    v_and_b32 v27, v15, v46
    v_and_b32 v84, v12, v61
    v_and_b32 v85, v13, v61
    v_and_b32 v86, v14, v61
    v_and_b32 v87, v15, v61
    s_waitcnt vmcnt(15)
    v_mfma_f32_16x16x32_bf16 v[16:19], v[28:31], v[148:151], v[16:19]
    v_xor_b32 v7, 0x14400, v7
    global_load_dwordx4 v[148:151], v7, s[8:9] nt
    v_and_b32 v28, v12, v47
    v_and_b32 v29, v13, v47
    v_and_b32 v30, v14, v47
    v_and_b32 v31, v15, v47
    v_and_b32 v88, v12, v62
    v_and_b32 v89, v13, v62
    v_and_b32 v90, v14, v62
    v_and_b32 v91, v15, v62
    s_waitcnt vmcnt(15)
    v_mfma_f32_16x16x32_bf16 v[16:19], v[24:27], v[152:155], v[16:19]
    v_xor_b32 v7, 0x21900, v7
    global_load_dwordx4 v[152:155], v7, s[8:9] nt
    v_and_b32 v24, v12, v48
    v_and_b32 v25, v13, v48
    v_and_b32 v26, v14, v48
    v_and_b32 v27, v15, v48
    v_and_b32 v92, v12, v63
    v_and_b32 v93, v13, v63
    v_and_b32 v94, v14, v63
    v_and_b32 v95, v15, v63
    s_waitcnt vmcnt(15)
    v_mfma_f32_16x16x32_bf16 v[16:19], v[28:31], v[156:159], v[16:19]
    v_xor_b32 v7, 0x14400, v7
    global_load_dwordx4 v[156:159], v7, s[8:9] nt
    v_and_b32 v28, v12, v49
    v_and_b32 v29, v13, v49
    v_and_b32 v30, v14, v49
    v_and_b32 v31, v15, v49
    s_waitcnt lgkmcnt(0)
    s_barrier
    s_waitcnt vmcnt(15)
    v_mfma_f32_16x16x32_bf16 v[16:19], v[24:27], v[96:99], v[16:19]
    v_and_b32 v24, v12, v50
    v_and_b32 v25, v13, v50
    v_and_b32 v26, v14, v50
    v_and_b32 v27, v15, v50
    s_waitcnt vmcnt(14)
    v_mfma_f32_16x16x32_bf16 v[16:19], v[28:31], v[100:103], v[16:19]
    v_and_b32 v28, v12, v51
    v_and_b32 v29, v13, v51
    v_and_b32 v30, v14, v51
    v_and_b32 v31, v15, v51
    s_waitcnt vmcnt(13)
    v_mfma_f32_16x16x32_bf16 v[16:19], v[24:27], v[104:107], v[16:19]
    v_and_b32 v24, v12, v52
    v_and_b32 v25, v13, v52
    v_and_b32 v26, v14, v52
    v_and_b32 v27, v15, v52
    s_waitcnt vmcnt(12)
    v_mfma_f32_16x16x32_bf16 v[16:19], v[28:31], v[108:111], v[16:19]
    v_and_b32 v28, v12, v53
    v_and_b32 v29, v13, v53
    v_and_b32 v30, v14, v53
    v_and_b32 v31, v15, v53
    s_waitcnt vmcnt(11)
    v_mfma_f32_16x16x32_bf16 v[16:19], v[24:27], v[112:115], v[16:19]
    v_and_b32 v24, v12, v54
    v_and_b32 v25, v13, v54
    v_and_b32 v26, v14, v54
    v_and_b32 v27, v15, v54
    s_waitcnt vmcnt(10)
    v_mfma_f32_16x16x32_bf16 v[16:19], v[28:31], v[116:119], v[16:19]
    v_and_b32 v28, v12, v55
    v_and_b32 v29, v13, v55
    v_and_b32 v30, v14, v55
    v_and_b32 v31, v15, v55
    s_waitcnt vmcnt(9)
    v_mfma_f32_16x16x32_bf16 v[16:19], v[24:27], v[120:123], v[16:19]
    s_waitcnt vmcnt(8)
    v_mfma_f32_16x16x32_bf16 v[16:19], v[28:31], v[124:127], v[16:19]
    s_waitcnt vmcnt(7)
    v_mfma_f32_16x16x32_bf16 v[16:19], v[64:67], v[128:131], v[16:19]
    s_waitcnt vmcnt(6)
    v_mfma_f32_16x16x32_bf16 v[16:19], v[68:71], v[132:135], v[16:19]
    s_waitcnt vmcnt(5)
    v_mfma_f32_16x16x32_bf16 v[16:19], v[72:75], v[136:139], v[16:19]
    s_waitcnt vmcnt(4)
    v_mfma_f32_16x16x32_bf16 v[16:19], v[76:79], v[140:143], v[16:19]
    s_waitcnt vmcnt(3)
    v_mfma_f32_16x16x32_bf16 v[16:19], v[80:83], v[144:147], v[16:19]
    s_waitcnt vmcnt(2)
    v_mfma_f32_16x16x32_bf16 v[16:19], v[84:87], v[148:151], v[16:19]
    s_waitcnt vmcnt(1)
    v_mfma_f32_16x16x32_bf16 v[16:19], v[88:91], v[152:155], v[16:19]
    s_waitcnt vmcnt(0)
    v_mfma_f32_16x16x32_bf16 v[16:19], v[92:95], v[156:159], v[16:19]
    s_nop 7
    ds_write_b128 v5, v[16:19]
    s_waitcnt lgkmcnt(0)
    s_barrier
    s_endpgm

L_last:
    s_load_dwordx2 s[20:21], s[0:1], 64
    s_lshl_b32 s3, s22, 3
    s_add_u32 s3, s3, s23
    s_lshl_b32 s3, s3, 10
    v_lshlrev_b32 v5, 4, v1
    v_add_u32 v9, s3, v5
    v_lshlrev_b32 v4, 2, v1
    s_waitcnt lgkmcnt(0)
    s_barrier
    v_and_b32 v28, v12, v43
    v_and_b32 v29, v13, v43
    v_and_b32 v30, v14, v43
    v_and_b32 v31, v15, v43
    v_and_b32 v72, v12, v58
    v_and_b32 v73, v13, v58
    v_and_b32 v74, v14, v58
    v_and_b32 v75, v15, v58
    s_waitcnt vmcnt(15)
    v_mfma_f32_16x16x32_bf16 v[16:19], v[24:27], v[136:139], v[16:19]
    v_xor_b32 v7, 0x21900, v7
    global_load_dwordx4 v[136:139], v7, s[8:9] nt
    v_and_b32 v24, v12, v44
    v_and_b32 v25, v13, v44
    v_and_b32 v26, v14, v44
    v_and_b32 v27, v15, v44
    v_and_b32 v76, v12, v59
    v_and_b32 v77, v13, v59
    v_and_b32 v78, v14, v59
    v_and_b32 v79, v15, v59
    s_waitcnt vmcnt(15)
    v_mfma_f32_16x16x32_bf16 v[16:19], v[28:31], v[140:143], v[16:19]
    v_xor_b32 v7, 0x14400, v7
    global_load_dwordx4 v[140:143], v7, s[8:9] nt
    v_and_b32 v28, v12, v45
    v_and_b32 v29, v13, v45
    v_and_b32 v30, v14, v45
    v_and_b32 v31, v15, v45
    v_and_b32 v80, v12, v60
    v_and_b32 v81, v13, v60
    v_and_b32 v82, v14, v60
    v_and_b32 v83, v15, v60
    s_waitcnt vmcnt(15)
    v_mfma_f32_16x16x32_bf16 v[16:19], v[24:27], v[144:147], v[16:19]
    v_xor_b32 v7, 0xe6800, v7
    global_load_dwordx4 v[144:147], v7, s[8:9] nt
    v_and_b32 v24, v12, v46
    v_and_b32 v25, v13, v46
    v_and_b32 v26, v14, v46
    v_and_b32 v27, v15, v46
    v_and_b32 v84, v12, v61
    v_and_b32 v85, v13, v61
    v_and_b32 v86, v14, v61
    v_and_b32 v87, v15, v61
    s_waitcnt vmcnt(15)
    v_mfma_f32_16x16x32_bf16 v[16:19], v[28:31], v[148:151], v[16:19]
    v_xor_b32 v7, 0x14400, v7
    global_load_dwordx4 v[148:151], v7, s[8:9] nt
    v_and_b32 v28, v12, v47
    v_and_b32 v29, v13, v47
    v_and_b32 v30, v14, v47
    v_and_b32 v31, v15, v47
    v_and_b32 v88, v12, v62
    v_and_b32 v89, v13, v62
    v_and_b32 v90, v14, v62
    v_and_b32 v91, v15, v62
    s_waitcnt vmcnt(15)
    v_mfma_f32_16x16x32_bf16 v[16:19], v[24:27], v[152:155], v[16:19]
    v_xor_b32 v7, 0x21900, v7
    global_load_dwordx4 v[152:155], v7, s[8:9] nt
    v_and_b32 v24, v12, v48
    v_and_b32 v25, v13, v48
    v_and_b32 v26, v14, v48
    v_and_b32 v27, v15, v48
    v_and_b32 v92, v12, v63
    v_and_b32 v93, v13, v63
    v_and_b32 v94, v14, v63
    v_and_b32 v95, v15, v63
    s_waitcnt vmcnt(15)
    v_mfma_f32_16x16x32_bf16 v[16:19], v[28:31], v[156:159], v[16:19]
    v_xor_b32 v7, 0x14400, v7
    global_load_dwordx4 v[156:159], v7, s[8:9] nt
    v_and_b32 v28, v12, v49
    v_and_b32 v29, v13, v49
    v_and_b32 v30, v14, v49
    v_and_b32 v31, v15, v49
    s_mov_b32 exec_lo, 0x1010101
    s_mov_b32 exec_hi, 0x1010101
    global_load_dword v160, v9, s[20:21] sc1
    s_mov_b64 exec, -1
    s_waitcnt vmcnt(16)
    v_mfma_f32_16x16x32_bf16 v[16:19], v[24:27], v[96:99], v[16:19]
    v_and_b32 v24, v12, v50
    v_and_b32 v25, v13, v50
    v_and_b32 v26, v14, v50
    v_and_b32 v27, v15, v50
    s_waitcnt vmcnt(15)
    v_mfma_f32_16x16x32_bf16 v[16:19], v[28:31], v[100:103], v[16:19]
    v_and_b32 v28, v12, v51
    v_and_b32 v29, v13, v51
    v_and_b32 v30, v14, v51
    v_and_b32 v31, v15, v51
    s_waitcnt vmcnt(14)
    v_mfma_f32_16x16x32_bf16 v[16:19], v[24:27], v[104:107], v[16:19]
    v_and_b32 v24, v12, v52
    v_and_b32 v25, v13, v52
    v_and_b32 v26, v14, v52
    v_and_b32 v27, v15, v52
    s_waitcnt vmcnt(13)
    v_mfma_f32_16x16x32_bf16 v[16:19], v[28:31], v[108:111], v[16:19]
    v_and_b32 v28, v12, v53
    v_and_b32 v29, v13, v53
    v_and_b32 v30, v14, v53
    v_and_b32 v31, v15, v53
    s_waitcnt vmcnt(12)
    v_mfma_f32_16x16x32_bf16 v[16:19], v[24:27], v[112:115], v[16:19]
    v_and_b32 v24, v12, v54
    v_and_b32 v25, v13, v54
    v_and_b32 v26, v14, v54
    v_and_b32 v27, v15, v54
    s_waitcnt vmcnt(11)
    v_mfma_f32_16x16x32_bf16 v[16:19], v[28:31], v[116:119], v[16:19]
    v_and_b32 v28, v12, v55
    v_and_b32 v29, v13, v55
    v_and_b32 v30, v14, v55
    v_and_b32 v31, v15, v55
    s_waitcnt vmcnt(10)
    v_mfma_f32_16x16x32_bf16 v[16:19], v[24:27], v[120:123], v[16:19]
    s_waitcnt vmcnt(9)
    v_mfma_f32_16x16x32_bf16 v[16:19], v[28:31], v[124:127], v[16:19]
    s_waitcnt vmcnt(8)
    v_mfma_f32_16x16x32_bf16 v[16:19], v[64:67], v[128:131], v[16:19]
    s_waitcnt vmcnt(7)
    v_mfma_f32_16x16x32_bf16 v[16:19], v[68:71], v[132:135], v[16:19]
    s_barrier
    ds_read_b128 v[44:47], v5 offset:3072
    ds_read_b128 v[32:35], v5 offset:0
    ds_read_b128 v[36:39], v5 offset:1024
    ds_read_b128 v[40:43], v5 offset:2048
    ds_read_b32 v52, v4 offset:4160
    s_waitcnt vmcnt(6)
    v_mfma_f32_16x16x32_bf16 v[16:19], v[72:75], v[136:139], v[16:19]
    s_waitcnt vmcnt(5)
    v_mfma_f32_16x16x32_bf16 v[16:19], v[76:79], v[140:143], v[16:19]
    s_waitcnt vmcnt(4)
    v_mfma_f32_16x16x32_bf16 v[16:19], v[80:83], v[144:147], v[16:19]
    s_waitcnt vmcnt(3)
    v_mfma_f32_16x16x32_bf16 v[16:19], v[84:87], v[148:151], v[16:19]
    s_waitcnt vmcnt(2)
    v_mfma_f32_16x16x32_bf16 v[16:19], v[88:91], v[152:155], v[16:19]
    s_waitcnt vmcnt(1)
    v_mfma_f32_16x16x32_bf16 v[16:19], v[92:95], v[156:159], v[16:19]
    s_waitcnt lgkmcnt(0)
    v_cmp_ne_u32 vcc, 0, v52
    v_pk_mul_f32 v[48:49], v[44:45], v[32:33] op_sel:[0,0] op_sel_hi:[0,1]
    v_pk_mul_f32 v[50:51], v[44:45], v[34:35] op_sel:[0,0] op_sel_hi:[0,1]
    v_pk_fma_f32 v[48:49], v[44:45], v[36:37], v[48:49] op_sel:[1,0,0] op_sel_hi:[1,1,1]
    v_pk_fma_f32 v[50:51], v[44:45], v[38:39], v[50:51] op_sel:[1,0,0] op_sel_hi:[1,1,1]
    v_pk_fma_f32 v[48:49], v[46:47], v[40:41], v[48:49] op_sel:[0,0,0] op_sel_hi:[0,1,1]
    v_pk_fma_f32 v[50:51], v[46:47], v[42:43], v[50:51] op_sel:[0,0,0] op_sel_hi:[0,1,1]
    v_pk_fma_f32 v[48:49], v[46:47], v[16:17], v[48:49] op_sel:[1,0,0] op_sel_hi:[1,1,1]
    v_pk_fma_f32 v[50:51], v[46:47], v[18:19], v[50:51] op_sel:[1,0,0] op_sel_hi:[1,1,1]
    s_cbranch_vccnz L_lastslow
    global_store_dwordx4 v9, v[48:51], s[20:21]
    s_endpgm
L_lastslow:
    global_store_dwordx4 v9, v[48:51], s[20:21] sc1
    s_endpgm

L_cons:
    v_lshl_add_u32 v3, v2, 3, v9
    s_mov_b32 exec_lo, 0xff
    s_mov_b32 exec_hi, 0xff
    global_store_dwordx2 v3, v[16:17], s[20:21]
    s_mov_b64 exec, -1
    s_cmp_lg_u32 s2, 0
    s_cbranch_scc1 L_cnolead
    v_add_u32 v119, 278528, v7
    global_store_dwordx4 v119, v[16:19], s[20:21] offset:0 sc1
    v_mov_b32 v119, 0
    s_mov_b64 exec, 0x1
    s_waitcnt vmcnt(0)
    global_store_dword v119, v16, s[18:19] offset:192 sc1
    s_mov_b64 exec, -1
L_cnolead:
    v_add_u32 v9, -24, v3
    v_bfe_u32 v3, v0, 4, 1
    v_lshlrev_b32 v3, 3, v3
    v_lshl_add_u32 v3, v2, 4, v3
    s_lshl_b32 s3, s22, 8
    v_add_u32 v119, s3, v3
    v_lshl_add_u32 v12, v6, 8, v119
    v_add_u32 v12, s3, v12
    v_add_u32 v15, -3, v2
    v_add_u32 v15, s37, v15
    v_lshlrev_b32 v15, v15, 1
    v_mov_b32 v2, s28
    v_mov_b32 v10, 0xff800000
    v_mov_b32 v11, 0
    s_mov_b32 s29, 4194304
    s_mov_b64 exec, 0x1
    s_barrier
    s_barrier
    s_load_dword s35, s[18:19], 192
    s_waitcnt lgkmcnt(0)
    s_cmp_eq_u32 s35, 0
    s_cselect_b32 s3, s30, s34
    s_cselect_b64 s[32:33], s[18:19], s[20:21]
    v_mov_b32 v3, s3
    s_waitcnt vmcnt(0)
    global_store_dword v3, v2, s[32:33]
    s_mov_b32 exec_lo, 0xf000f
    s_mov_b32 exec_hi, 0xf000f
    s_barrier
    s_barrier
    s_load_dword s31, s[14:15], 0
    ds_read_b64 v[10:11], v4 offset:4096
    s_mov_b64 exec, -1
    global_load_dwordx2 v[112:113], v12, s[4:5]
    global_load_dwordx2 v[114:115], v119, s[10:11]
    global_load_dwordx2 v[116:117], v119, s[12:13]
    s_mov_b64 exec, 0x10
    global_load_dword v160, v9, s[20:21] sc1
    global_load_dword v160, v5, s[18:19] offset:128 sc1
    s_mov_b64 exec, -1
    s_and_b32 s3, s22, 16
    s_mov_b32 s30, 0
    s_waitcnt lgkmcnt(0)
    s_lshr_b32 s31, s31, s3
    s_lshl_b32 s31, s31, 16
    v_sub_f32 v120, 1.0, s31
    v_mul_f32 v120, 0xceabfb8f, v120
    s_mov_b32 exec_lo, 0x7f007f0
    s_mov_b32 exec_hi, 0x7f007f0
    s_waitcnt vmcnt(0)
L_cml:
    global_load_dwordx2 v[10:11], v9, s[20:21] sc1
    global_load_dword v124, v5, s[18:19] offset:128 sc1
    s_cmp_lg_u32 s30, 0
    s_cbranch_scc1 L_cml_g
L_cml_a:
    s_sub_u32 s29, s29, 1
    s_cbranch_scc1 L_cml_done
    s_waitcnt vmcnt(0)
    v_max_u32 v2, v10, v11
    v_cmp_eq_u32 vcc, -1, v2
    v_readfirstlane_b32 s30, v124
    s_cbranch_vccnz L_cml
L_cml_done:
    s_mov_b64 exec, -1
    global_load_dwordx4 v[56:59], v8, s[20:21] offset:-3072 sc1
    global_load_dwordx4 v[60:63], v8, s[20:21] offset:-2048 sc1
    global_load_dwordx4 v[64:67], v8, s[20:21] offset:-1024 sc1
    global_load_dwordx4 v[68:71], v8, s[20:21] offset:0 sc1
    global_load_dwordx4 v[72:75], v8, s[20:21] offset:1024 sc1
    global_load_dwordx4 v[76:79], v8, s[20:21] offset:2048 sc1
    global_load_dwordx4 v[80:83], v8, s[20:21] offset:3072 sc1
    s_barrier
    ds_read_b128 v[40:43], v7 offset:0
    ds_read_b128 v[44:47], v7 offset:1024
    ds_read_b128 v[48:51], v7 offset:2048
    ds_read_b128 v[52:55], v7 offset:3072
    v_dot2_f32_bf16 v118, v112, v114, 0
    v_dot2_f32_bf16 v118, v113, v115, v118
    v_max_f32_dpp v14, v10, v10 quad_perm:[1,0,3,2] row_mask:0xf bank_mask:0xf
    v_lshlrev_b32 v20, 16, v116
    v_and_b32 v21, 0xffff0000, v116
    v_add_f32_dpp v118, v118, v118 quad_perm:[1,0,3,2] row_mask:0xf bank_mask:0xf
    v_max_f32_dpp v14, v14, v14 quad_perm:[2,3,0,1] row_mask:0xf bank_mask:0xf
    v_lshlrev_b32 v22, 16, v117
    v_add_f32_dpp v118, v118, v118 quad_perm:[2,3,0,1] row_mask:0xf bank_mask:0xf
    v_max_f32_dpp v14, v14, v14 row_half_mirror row_mask:0xf bank_mask:0xf
    v_and_b32 v23, 0xffff0000, v117
    v_add_f32_dpp v118, v118, v118 row_half_mirror row_mask:0xf bank_mask:0xf
    v_max_f32_dpp v14, v14, v14 row_mirror row_mask:0xf bank_mask:0xf
    s_mov_b32 s29, 4194304
    v_add_f32_dpp v118, v118, v118 row_mirror row_mask:0xf bank_mask:0xf
    v_mov_b32 v2, v118
    s_nop 1
    v_permlane16_swap_b32 v118, v2
    s_nop 0
    v_add_f32 v118, v118, v2
    v_cvt_pk_bf16_f32 v118, 0, v118
    v_mul_f32 v118, 0x3db504f3, v118
    v_cvt_pk_bf16_f32 v118, 0, v118
    v_fma_f32 v118, v118, s26, v120
    v_max_f32 v14, v14, v118
    v_sub_f32 v13, v10, v14
    v_sub_f32 v35, v118, v14
    v_exp_f32 v13, v13
    v_exp_f32 v35, v35
    v_mul_f32 v11, v13, v11
    v_mov_b32_dpp v24, v13 row_newbcast:0 row_mask:0xf bank_mask:0xf
    v_mov_b32_dpp v25, v13 row_newbcast:1 row_mask:0xf bank_mask:0xf
    v_add_f32_dpp v11, v11, v11 quad_perm:[1,0,3,2] row_mask:0xf bank_mask:0xf
    v_mov_b32_dpp v26, v13 row_newbcast:2 row_mask:0xf bank_mask:0xf
    v_mov_b32_dpp v27, v13 row_newbcast:3 row_mask:0xf bank_mask:0xf
    v_add_f32_dpp v11, v11, v11 quad_perm:[2,3,0,1] row_mask:0xf bank_mask:0xf
    v_mov_b32_dpp v28, v13 row_newbcast:4 row_mask:0xf bank_mask:0xf
    v_mov_b32_dpp v29, v13 row_newbcast:5 row_mask:0xf bank_mask:0xf
    v_add_f32_dpp v11, v11, v11 row_half_mirror row_mask:0xf bank_mask:0xf
    v_mov_b32_dpp v30, v13 row_newbcast:6 row_mask:0xf bank_mask:0xf
    v_mov_b32_dpp v31, v13 row_newbcast:7 row_mask:0xf bank_mask:0xf
    v_add_f32_dpp v11, v11, v11 row_mirror row_mask:0xf bank_mask:0xf
    v_add_f32 v11, v11, v35
    v_rcp_f32 v11, v11
    v_mov_b32_dpp v32, v13 row_newbcast:8 row_mask:0xf bank_mask:0xf
    v_mov_b32_dpp v33, v13 row_newbcast:9 row_mask:0xf bank_mask:0xf
    v_mov_b32_dpp v34, v13 row_newbcast:10 row_mask:0xf bank_mask:0xf
    global_load_dwordx4 v[84:87], v8, s[20:21] offset:-3072 sc1
    global_load_dwordx4 v[88:91], v8, s[20:21] offset:-2048 sc1
    global_load_dwordx4 v[92:95], v8, s[20:21] offset:-1024 sc1
    global_load_dwordx4 v[96:99], v8, s[20:21] offset:0 sc1
    global_load_dwordx4 v[100:103], v8, s[20:21] offset:1024 sc1
    global_load_dwordx4 v[104:107], v8, s[20:21] offset:2048 sc1
    global_load_dwordx4 v[108:111], v8, s[20:21] offset:3072 sc1
    v_pk_mul_f32 v[34:35], v[34:35], v[10:11] op_sel:[0,1] op_sel_hi:[1,1]
    v_pk_mul_f32 v[24:25], v[24:25], v[10:11] op_sel:[0,1] op_sel_hi:[1,1]
    v_pk_mul_f32 v[26:27], v[26:27], v[10:11] op_sel:[0,1] op_sel_hi:[1,1]
    v_pk_mul_f32 v[28:29], v[28:29], v[10:11] op_sel:[0,1] op_sel_hi:[1,1]
    v_pk_mul_f32 v[30:31], v[30:31], v[10:11] op_sel:[0,1] op_sel_hi:[1,1]
    v_pk_mul_f32 v[32:33], v[32:33], v[10:11] op_sel:[0,1] op_sel_hi:[1,1]
    v_pk_mul_f32 v[16:17], v[34:35], v[20:21] op_sel:[1,0] op_sel_hi:[1,1]
    v_pk_mul_f32 v[18:19], v[34:35], v[22:23] op_sel:[1,0] op_sel_hi:[1,1]
    s_waitcnt lgkmcnt(0)
    v_pk_fma_f32 v[16:17], v[24:25], v[40:41], v[16:17] op_sel:[0,0,0] op_sel_hi:[0,1,1]
    v_pk_fma_f32 v[18:19], v[24:25], v[42:43], v[18:19] op_sel:[0,0,0] op_sel_hi:[0,1,1]
    v_pk_fma_f32 v[16:17], v[24:25], v[44:45], v[16:17] op_sel:[1,0,0] op_sel_hi:[1,1,1]
    v_pk_fma_f32 v[18:19], v[24:25], v[46:47], v[18:19] op_sel:[1,0,0] op_sel_hi:[1,1,1]
    v_pk_fma_f32 v[16:17], v[26:27], v[48:49], v[16:17] op_sel:[0,0,0] op_sel_hi:[0,1,1]
    v_pk_fma_f32 v[18:19], v[26:27], v[50:51], v[18:19] op_sel:[0,0,0] op_sel_hi:[0,1,1]
    v_pk_fma_f32 v[16:17], v[26:27], v[52:53], v[16:17] op_sel:[1,0,0] op_sel_hi:[1,1,1]
    v_pk_fma_f32 v[18:19], v[26:27], v[54:55], v[18:19] op_sel:[1,0,0] op_sel_hi:[1,1,1]
L_cpoll:
    s_waitcnt vmcnt(13)
    v_pk_fma_f32 v[36:37], v[28:29], v[56:57], v[16:17] op_sel:[0,0,0] op_sel_hi:[0,1,1]
    v_pk_fma_f32 v[38:39], v[28:29], v[58:59], v[18:19] op_sel:[0,0,0] op_sel_hi:[0,1,1]
    s_waitcnt vmcnt(12)
    v_pk_fma_f32 v[36:37], v[28:29], v[60:61], v[36:37] op_sel:[1,0,0] op_sel_hi:[1,1,1]
    v_pk_fma_f32 v[38:39], v[28:29], v[62:63], v[38:39] op_sel:[1,0,0] op_sel_hi:[1,1,1]
    s_waitcnt vmcnt(11)
    v_pk_fma_f32 v[36:37], v[30:31], v[64:65], v[36:37] op_sel:[0,0,0] op_sel_hi:[0,1,1]
    v_pk_fma_f32 v[38:39], v[30:31], v[66:67], v[38:39] op_sel:[0,0,0] op_sel_hi:[0,1,1]
    s_waitcnt vmcnt(10)
    v_pk_fma_f32 v[36:37], v[30:31], v[68:69], v[36:37] op_sel:[1,0,0] op_sel_hi:[1,1,1]
    v_pk_fma_f32 v[38:39], v[30:31], v[70:71], v[38:39] op_sel:[1,0,0] op_sel_hi:[1,1,1]
    s_waitcnt vmcnt(9)
    v_pk_fma_f32 v[36:37], v[32:33], v[72:73], v[36:37] op_sel:[0,0,0] op_sel_hi:[0,1,1]
    v_pk_fma_f32 v[38:39], v[32:33], v[74:75], v[38:39] op_sel:[0,0,0] op_sel_hi:[0,1,1]
    s_waitcnt vmcnt(8)
    v_pk_fma_f32 v[36:37], v[32:33], v[76:77], v[36:37] op_sel:[1,0,0] op_sel_hi:[1,1,1]
    v_pk_fma_f32 v[38:39], v[32:33], v[78:79], v[38:39] op_sel:[1,0,0] op_sel_hi:[1,1,1]
    s_waitcnt vmcnt(7)
    v_pk_fma_f32 v[36:37], v[34:35], v[80:81], v[36:37] op_sel:[0,0,0] op_sel_hi:[0,1,1]
    v_pk_fma_f32 v[38:39], v[34:35], v[82:83], v[38:39] op_sel:[0,0,0] op_sel_hi:[0,1,1]
    v_pk_add_f32 v[2:3], v[36:37], v[38:39]
    v_cvt_pk_bf16_f32 v10, v36, v37
    v_cmp_u_f32 vcc, v2, v3
    v_cvt_pk_bf16_f32 v11, v38, v39
    s_cbranch_vccz L_cout
    global_load_dwordx4 v[56:59], v8, s[20:21] offset:-3072 sc1
    global_load_dwordx4 v[60:63], v8, s[20:21] offset:-2048 sc1
    global_load_dwordx4 v[64:67], v8, s[20:21] offset:-1024 sc1
    global_load_dwordx4 v[68:71], v8, s[20:21] offset:0 sc1
    global_load_dwordx4 v[72:75], v8, s[20:21] offset:1024 sc1
    global_load_dwordx4 v[76:79], v8, s[20:21] offset:2048 sc1
    global_load_dwordx4 v[80:83], v8, s[20:21] offset:3072 sc1
L_cmid:
    s_waitcnt vmcnt(13)
    v_pk_fma_f32 v[36:37], v[28:29], v[84:85], v[16:17] op_sel:[0,0,0] op_sel_hi:[0,1,1]
    v_pk_fma_f32 v[38:39], v[28:29], v[86:87], v[18:19] op_sel:[0,0,0] op_sel_hi:[0,1,1]
    s_waitcnt vmcnt(12)
    v_pk_fma_f32 v[36:37], v[28:29], v[88:89], v[36:37] op_sel:[1,0,0] op_sel_hi:[1,1,1]
    v_pk_fma_f32 v[38:39], v[28:29], v[90:91], v[38:39] op_sel:[1,0,0] op_sel_hi:[1,1,1]
    s_waitcnt vmcnt(11)
    v_pk_fma_f32 v[36:37], v[30:31], v[92:93], v[36:37] op_sel:[0,0,0] op_sel_hi:[0,1,1]
    v_pk_fma_f32 v[38:39], v[30:31], v[94:95], v[38:39] op_sel:[0,0,0] op_sel_hi:[0,1,1]
    s_waitcnt vmcnt(10)
    v_pk_fma_f32 v[36:37], v[30:31], v[96:97], v[36:37] op_sel:[1,0,0] op_sel_hi:[1,1,1]
    v_pk_fma_f32 v[38:39], v[30:31], v[98:99], v[38:39] op_sel:[1,0,0] op_sel_hi:[1,1,1]
    s_waitcnt vmcnt(9)
    v_pk_fma_f32 v[36:37], v[32:33], v[100:101], v[36:37] op_sel:[0,0,0] op_sel_hi:[0,1,1]
    v_pk_fma_f32 v[38:39], v[32:33], v[102:103], v[38:39] op_sel:[0,0,0] op_sel_hi:[0,1,1]
    s_waitcnt vmcnt(8)
    v_pk_fma_f32 v[36:37], v[32:33], v[104:105], v[36:37] op_sel:[1,0,0] op_sel_hi:[1,1,1]
    v_pk_fma_f32 v[38:39], v[32:33], v[106:107], v[38:39] op_sel:[1,0,0] op_sel_hi:[1,1,1]
    s_waitcnt vmcnt(7)
    v_pk_fma_f32 v[36:37], v[34:35], v[108:109], v[36:37] op_sel:[0,0,0] op_sel_hi:[0,1,1]
    v_pk_fma_f32 v[38:39], v[34:35], v[110:111], v[38:39] op_sel:[0,0,0] op_sel_hi:[0,1,1]
    v_pk_add_f32 v[2:3], v[36:37], v[38:39]
    v_cvt_pk_bf16_f32 v10, v36, v37
    v_cmp_u_f32 vcc, v2, v3
    v_cvt_pk_bf16_f32 v11, v38, v39
    s_cbranch_vccnz L_cretry
L_cout:
    global_store_dwordx2 v12, v[10:11], s[16:17]
    s_endpgm
L_cretry:
    s_sub_u32 s29, s29, 1
    s_cbranch_scc1 L_cout
    s_and_b32 s3, s29, 15
    s_cbranch_scc0 L_cexact
L_crepoll:
    global_load_dwordx4 v[84:87], v8, s[20:21] offset:-3072 sc1
    global_load_dwordx4 v[88:91], v8, s[20:21] offset:-2048 sc1
    global_load_dwordx4 v[92:95], v8, s[20:21] offset:-1024 sc1
    global_load_dwordx4 v[96:99], v8, s[20:21] offset:0 sc1
    global_load_dwordx4 v[100:103], v8, s[20:21] offset:1024 sc1
    global_load_dwordx4 v[104:107], v8, s[20:21] offset:2048 sc1
    global_load_dwordx4 v[108:111], v8, s[20:21] offset:3072 sc1
L_cagain:
    s_branch L_cpoll

L_helper:
    s_setprio 3
    s_bitcmp1_b32 s2, 0
    s_cselect_b32 s22, 16, 0
    s_bitcmp1_b32 s2, 1
    s_cselect_b32 s3, 9, 0
    s_xor_b32 s22, s22, s3
    s_bitcmp1_b32 s2, 2
    s_cselect_b32 s3, 5, 0
    s_xor_b32 s22, s22, s3
    s_bitcmp1_b32 s2, 3
    s_cselect_b32 s3, 1, 0
    s_xor_b32 s22, s22, s3
    s_bitcmp1_b32 s2, 4
    s_cselect_b32 s3, 2, 0
    s_xor_b32 s22, s22, s3
    s_lshr_b32 s23, s2, 5
    s_mov_b32 s26, 0x3fb8aa3b
    s_getreg_b32 s28, hwreg(HW_REG_XCC_ID, 0, 4)
    s_or_b32 s28, s28, 0x100
    v_lshrrev_b32 v6, 5, v1
    v_lshlrev_b32 v7, 4, v1
    v_and_b32 v2, 15, v0
    s_lshl_b32 s3, s22, 13
    s_add_u32 s3, s3, 4096
    v_add_u32 v8, s3, v7
    s_lshl_b32 s3, s22, 8
    s_add_u32 s3, s3, 262144
    v_lshl_add_u32 v9, v6, 6, s3
    s_and_b32 s34, s2, 7
    s_lshl_b32 s34, s34, 5
    s_bfe_u32 s3, s2, 0x20003
    s_add_u32 s34, s34, s3
    s_lshl_b32 s34, s34, 2
    s_add_u32 s34, s34, 278528
    v_and_b32 v4, 3, v0
    v_lshlrev_b32 v4, 3, v4
    v_lshl_add_u32 v4, v6, 5, v4
    s_lshl_b32 s30, s22, 2
    s_and_b32 s3, s22, 28
    v_mov_b32 v5, s3
    s_and_b32 s37, s22, 3
    s_lshl_b32 s37, s37, 3
    v_mov_b32 v16, -1
    v_mov_b32 v17, -1
    v_mov_b32 v18, -1
    v_mov_b32 v19, -1
    s_cmp_eq_u32 s23, 0
    s_waitcnt lgkmcnt(0)
    s_cbranch_scc1 L_cons
    s_lshl_b32 s3, s23, 10
    v_add_u32 v8, s3, v8
    s_lshl_b32 s3, s23, 3
    v_add_u32 v9, s3, v9
    global_store_dwordx4 v8, v[16:19], s[20:21] offset:-4096
    s_barrier
    s_barrier
    s_barrier
    s_waitcnt vmcnt(0)
    s_barrier
    s_load_dword s3, s[18:19], 192
    ds_read_b64 v[10:11], v4 offset:4096
    s_waitcnt lgkmcnt(0)
    s_mov_b32 s35, s3
    s_cmp_eq_u32 s3, 0
    s_cbranch_scc1 L_pnomark
    s_load_dword s3, s[20:21], s34
L_pnomark:
    v_max_f32_dpp v14, v10, v10 quad_perm:[1,0,3,2] row_mask:0xf bank_mask:0xf
    s_nop 1
    v_max_f32_dpp v14, v14, v14 quad_perm:[2,3,0,1] row_mask:0xf bank_mask:0xf
    v_sub_f32 v13, v10, v14
    v_exp_f32 v13, v13
    s_nop 0
    v_mul_f32 v15, v13, v11
    v_mov_b32_dpp v24, v13 row_newbcast:0 row_mask:0xf bank_mask:0xf
    v_mov_b32_dpp v25, v13 row_newbcast:1 row_mask:0xf bank_mask:0xf
    v_add_f32_dpp v15, v15, v15 quad_perm:[1,0,3,2] row_mask:0xf bank_mask:0xf
    v_mov_b32_dpp v26, v13 row_newbcast:2 row_mask:0xf bank_mask:0xf
    v_mov_b32_dpp v27, v13 row_newbcast:3 row_mask:0xf bank_mask:0xf
    v_add_f32_dpp v15, v15, v15 quad_perm:[2,3,0,1] row_mask:0xf bank_mask:0xf
    s_waitcnt lgkmcnt(0)
    s_cmp_lg_u32 s3, s28
    s_cbranch_scc1 L_pretry
L_pmlfast:
    s_mov_b32 exec_lo, 0x1
    s_mov_b32 exec_hi, 0x1
    global_store_dwordx2 v9, v[14:15], s[20:21]
L_pmldone:
    s_mov_b64 exec, -1
    s_cselect_b32 s3, 1, 0
    v_mov_b32 v2, s3
    v_lshlrev_b32 v3, 2, v1
    ds_write_b128 v7, v[24:27] offset:3072
    ds_write_b32 v3, v2 offset:4160
    s_waitcnt lgkmcnt(0)
    s_barrier
    s_endpgm
L_pretry:
    s_load_dword s3, s[18:19], s30
    s_waitcnt lgkmcnt(0)
    s_cmp_lg_u32 s3, s28
    s_cbranch_scc0 L_pmlfast
    s_cmp_lg_u32 s35, 0
    s_cbranch_scc1 L_pmlslow
    s_load_dword s35, s[18:19], 192 glc
    s_waitcnt lgkmcnt(0)
    s_cmp_eq_u32 s35, 0
    s_cbranch_scc1 L_pmlslow
    s_load_dword s3, s[20:21], s34
    s_waitcnt lgkmcnt(0)
    s_cmp_lg_u32 s3, s28
    s_cbranch_scc0 L_pmlfast
L_pmlslow:
    global_store_dwordx4 v8, v[16:19], s[20:21] offset:-4096 sc1
    s_mov_b32 exec_lo, 0x1
    s_mov_b32 exec_hi, 0x1
    global_store_dwordx2 v9, v[14:15], s[20:21] offset:128 sc1
    s_lshl_b32 s30, 1, s23
    s_lshl_b32 s30, s30, s37
    v_mov_b32 v2, s30
    s_mov_b64 exec, 0x1
    s_waitcnt vmcnt(0)
    global_atomic_or v5, v2, s[18:19] offset:128
    s_cmp_lg_u32 s3, s28
    s_branch L_pmldone

L_cexact:
    v_max3_u32 v2, v84, v85, v86
    v_max3_u32 v2, v2, v87, v88
    v_max3_u32 v2, v2, v89, v90
    v_max3_u32 v2, v2, v91, v92
    v_max3_u32 v2, v2, v93, v94
    v_max3_u32 v2, v2, v95, v96
    v_max3_u32 v2, v2, v97, v98
    v_max3_u32 v2, v2, v99, v100
    v_max3_u32 v2, v2, v101, v102
    v_max3_u32 v2, v2, v103, v104
    v_max3_u32 v2, v2, v105, v106
    v_max3_u32 v2, v2, v107, v108
    v_max3_u32 v2, v2, v109, v110
    v_max_u32 v2, v2, v111
    v_cmp_eq_u32 vcc, -1, v2
    s_cbranch_vccz L_cout
    s_branch L_crepoll
L_cml_g:
    global_load_dwordx2 v[122:123], v9, s[20:21] offset:128 sc1
    v_and_b32 v2, s30, v15
    v_cmp_ne_u32 vcc, 0, v2
    s_waitcnt vmcnt(0)
    s_nop 0
    v_cndmask_b32 v10, v10, v122, vcc
    v_cndmask_b32 v11, v11, v123, vcc
    s_branch L_cml_a
L_end:
    s_endpgm
.section .rodata,"a"
.p2align 6
.amdhsa_kernel standalone__tree_speculative_verify_tree_attention_over_candidate_token_tree__decode_kernel
  .amdhsa_next_free_vgpr 161
  .amdhsa_next_free_sgpr 40
  .amdhsa_accum_offset 164
  .amdhsa_group_segment_fixed_size 0
  .amdhsa_kernarg_size 72
  .amdhsa_user_sgpr_count 2
  .amdhsa_user_sgpr_kernarg_segment_ptr 1
  .amdhsa_system_sgpr_workgroup_id_x 1
  .amdhsa_float_denorm_mode_32 3
.end_amdhsa_kernel
```
